```python
import torch

def _softmax(x, axis=-1):
    return torch.softmax(x, dim=axis)
def _gelu(x):
    return torch.nn.functional.gelu(x, approximate="tanh")
def _silu(x):
    return torch.nn.functional.silu(x)
def _sigmoid(x):
    return torch.sigmoid(x)
def _layernorm(x, axis=-1, eps=1e-5):
    m = x.mean(dim=axis, keepdim=True)
    v = x.var(dim=axis, keepdim=True, unbiased=False)
    return (x - m) / torch.sqrt(v + eps)
def _scatter_add(tgt, idx, src, axis=0):
    return tgt.clone().index_add_(axis, idx, src)
def _segment_sum(src, seg, n):
    out = torch.zeros((n,) + src.shape[1:], dtype=src.dtype)
    return out.index_add_(0, seg, src)
def _pad(x, pw):
    flat = tuple(v for pair in reversed(pw) for v in pair)
    return torch.nn.functional.pad(x, flat)

kernel_name = 'standalone__rezero__sampling'

def setup_inputs():

    _w = (lambda a: (lambda t: t.to(torch.bfloat16) if t.is_floating_point() else t)(torch.as_tensor(a)))
    B, S, D = 1024, 8, 512
    return {
        "x": _w((lambda *s: torch.randn(*s, dtype=torch.bfloat16) * 0.05)(B, S, D)),
        "fx": _w((lambda *s: torch.randn(*s, dtype=torch.bfloat16) * 1.6)(B, S, D)),
        "alpha": _w((lambda *s: torch.randn(*s, dtype=torch.bfloat16) * 1.6)(1) * 0.1),
    }

def reference(x, fx, alpha):
    return x + alpha * fx
```

```asm
; @launch grid=(256,1,1) block=(1024,1,1) lds=0
.amdgcn_target "amdgcn-amd-amdhsa--gfx950"
.text
.p2align 12
.globl standalone__rezero__sampling_kernel
.p2align 8
.type standalone__rezero__sampling_kernel,@function
standalone__rezero__sampling_kernel:
    s_load_dwordx8 s[4:11], s[0:1], 0
    s_lshl_b32 s3, s2, 15
    v_lshl_add_u32 v0, v0, 4, s3
    s_cmpk_ge_u32 s2, 256
    s_cbranch_scc1 L_done
    v_add_u32 v1, 16384, v0
    s_waitcnt lgkmcnt(0)
    s_load_dword s12, s[8:9], 0
    global_load_dwordx4 v[12:15], v0, s[6:7]
    global_load_dwordx4 v[8:11], v0, s[4:5]
    s_mov_b32 s14, 0xffff0000
    s_waitcnt vmcnt(0)
    global_load_dwordx4 v[20:23], v1, s[6:7]
    global_load_dwordx4 v[16:19], v1, s[4:5]
    s_waitcnt lgkmcnt(0)
    s_lshl_b32 s12, s12, 16
    s_mov_b32 s13, s12
    v_lshlrev_b32 v24, 16, v12
    v_and_b32 v25, s14, v12
    v_lshlrev_b32 v28, 16, v13
    v_and_b32 v29, s14, v13
    v_lshlrev_b32 v32, 16, v14
    v_and_b32 v33, s14, v14
    v_lshlrev_b32 v36, 16, v15
    v_and_b32 v37, s14, v15
    v_pk_mul_f32 v[24:25], v[24:25], s[12:13]
    v_pk_mul_f32 v[28:29], v[28:29], s[12:13]
    v_pk_mul_f32 v[32:33], v[32:33], s[12:13]
    v_pk_mul_f32 v[36:37], v[36:37], s[12:13]
    v_cvt_pk_bf16_f32 v24, 0, v24
    v_cvt_pk_bf16_f32 v25, 0, v25
    v_cvt_pk_bf16_f32 v28, 0, v28
    v_cvt_pk_bf16_f32 v29, 0, v29
    v_cvt_pk_bf16_f32 v32, 0, v32
    v_cvt_pk_bf16_f32 v33, 0, v33
    v_cvt_pk_bf16_f32 v36, 0, v36
    v_cvt_pk_bf16_f32 v37, 0, v37
    v_lshlrev_b32 v26, 16, v8
    v_and_b32 v27, s14, v8
    v_lshlrev_b32 v30, 16, v9
    v_and_b32 v31, s14, v9
    v_lshlrev_b32 v34, 16, v10
    v_and_b32 v35, s14, v10
    v_lshlrev_b32 v38, 16, v11
    v_and_b32 v39, s14, v11
    v_pk_add_f32 v[26:27], v[26:27], v[24:25]
    v_pk_add_f32 v[30:31], v[30:31], v[28:29]
    v_pk_add_f32 v[34:35], v[34:35], v[32:33]
    v_pk_add_f32 v[38:39], v[38:39], v[36:37]
    v_cvt_pk_bf16_f32 v8, v26, v27
    v_cvt_pk_bf16_f32 v9, v30, v31
    v_cvt_pk_bf16_f32 v10, v34, v35
    v_cvt_pk_bf16_f32 v11, v38, v39
    global_store_dwordx4 v0, v[8:11], s[10:11]
    s_waitcnt vmcnt(2)
    v_lshlrev_b32 v24, 16, v20
    v_and_b32 v25, s14, v20
    v_lshlrev_b32 v28, 16, v21
    v_and_b32 v29, s14, v21
    v_lshlrev_b32 v32, 16, v22
    v_and_b32 v33, s14, v22
    v_lshlrev_b32 v36, 16, v23
    v_and_b32 v37, s14, v23
    v_pk_mul_f32 v[24:25], v[24:25], s[12:13]
    v_pk_mul_f32 v[28:29], v[28:29], s[12:13]
    v_pk_mul_f32 v[32:33], v[32:33], s[12:13]
    v_pk_mul_f32 v[36:37], v[36:37], s[12:13]
    v_cvt_pk_bf16_f32 v24, 0, v24
    v_cvt_pk_bf16_f32 v25, 0, v25
    v_cvt_pk_bf16_f32 v28, 0, v28
    v_cvt_pk_bf16_f32 v29, 0, v29
    v_cvt_pk_bf16_f32 v32, 0, v32
    v_cvt_pk_bf16_f32 v33, 0, v33
    v_cvt_pk_bf16_f32 v36, 0, v36
    v_cvt_pk_bf16_f32 v37, 0, v37
    s_waitcnt vmcnt(1)
    v_lshlrev_b32 v26, 16, v16
    v_and_b32 v27, s14, v16
    v_lshlrev_b32 v30, 16, v17
    v_and_b32 v31, s14, v17
    v_lshlrev_b32 v34, 16, v18
    v_and_b32 v35, s14, v18
    v_lshlrev_b32 v38, 16, v19
    v_and_b32 v39, s14, v19
    v_pk_add_f32 v[26:27], v[26:27], v[24:25]
    v_pk_add_f32 v[30:31], v[30:31], v[28:29]
    v_pk_add_f32 v[34:35], v[34:35], v[32:33]
    v_pk_add_f32 v[38:39], v[38:39], v[36:37]
    v_cvt_pk_bf16_f32 v16, v26, v27
    v_cvt_pk_bf16_f32 v17, v30, v31
    v_cvt_pk_bf16_f32 v18, v34, v35
    v_cvt_pk_bf16_f32 v19, v38, v39
    global_store_dwordx4 v1, v[16:19], s[10:11]
L_done:
    s_endpgm
.section .rodata,"a"
.p2align 6
.amdhsa_kernel standalone__rezero__sampling_kernel
  .amdhsa_next_free_vgpr 40
  .amdhsa_next_free_sgpr 16
  .amdhsa_accum_offset 40
  .amdhsa_group_segment_fixed_size 0
  .amdhsa_kernarg_size 48
  .amdhsa_user_sgpr_count 2
  .amdhsa_user_sgpr_kernarg_segment_ptr 1
  .amdhsa_system_sgpr_workgroup_id_x 1
  .amdhsa_float_denorm_mode_32 3
.end_amdhsa_kernel
```
